```python
import torch

def _softmax(x, axis=-1):
    return torch.softmax(x, dim=axis)
def _gelu(x):
    return torch.nn.functional.gelu(x, approximate="tanh")
def _silu(x):
    return torch.nn.functional.silu(x)
def _sigmoid(x):
    return torch.sigmoid(x)
def _layernorm(x, axis=-1, eps=1e-5):
    m = x.mean(dim=axis, keepdim=True)
    v = x.var(dim=axis, keepdim=True, unbiased=False)
    return (x - m) / torch.sqrt(v + eps)
def _scatter_add(tgt, idx, src, axis=0):
    return tgt.clone().index_add_(axis, idx, src)
def _segment_sum(src, seg, n):
    out = torch.zeros((n,) + src.shape[1:], dtype=src.dtype)
    return out.index_add_(0, seg, src)
def _pad(x, pw):
    flat = tuple(v for pair in reversed(pw) for v in pair)
    return torch.nn.functional.pad(x, flat)

kernel_name = 'standalone__kernel_systems_refs_ge_spmm__graph'

def setup_inputs():

    _w = (lambda a: (lambda t: t.to(torch.bfloat16) if t.is_floating_point() else t)(torch.as_tensor(a)))
    N, deg, D = 50000, 16, 64
    E = N * deg
    src = (lambda lo, hi, *s: torch.randint(lo, hi, s))(0, N, E).to(torch.int64)
    dst = (lambda lo, hi, *s: torch.randint(lo, hi, s))(0, N, E).to(torch.int64)
    e_w = (lambda *s: torch.randn(*s, dtype=torch.bfloat16) * 0.05)(E).to(float)
    return {
        "x": _w((lambda *s: torch.randn(*s, dtype=torch.bfloat16) * 0.05)(N, D).to(float)),
        "src": _w(src),
        "dst": _w(dst),
        "e_w": _w(e_w),
        "w": _w((lambda *s: torch.randn(*s, dtype=torch.bfloat16) * 0.05)(D, D).to(float)),
    }

def reference(x, src, dst, e_w, w):
    N = x.shape[0]
    h = x @ w
    msg = e_w[:, None] * h[src]
    return _segment_sum(msg, dst, N)
```

```asm
; @launch kernel=spmm_sort_kernel grid=(256,1,1) block=(1024,1,1) lds=27136
; @launch kernel=spmm_agg_kernel grid=(256,1,1) block=(1024,1,1) lds=106496
.amdgcn_target "amdgcn-amd-amdhsa--gfx950"
.text
.globl spmm_sort_kernel
.p2align 8
.type spmm_sort_kernel,@function
spmm_sort_kernel:
  s_cmp_ge_u32 s2, 256
  s_cbranch_scc1 K1_END
  s_load_dwordx2 s[4:5], s[0:1], 8
  s_load_dwordx2 s[6:7], s[0:1], 16
  s_load_dwordx2 s[8:9], s[0:1], 24
  s_load_dwordx2 s[10:11], s[0:1], 56
  s_load_dwordx2 s[12:13], s[0:1], 0
  s_mul_i32 s3, s2, 3125
  v_lshrrev_b32 v1, 6, v0
  s_nop 0
  v_readfirstlane_b32 s36, v1
  s_waitcnt lgkmcnt(0)
  s_mov_b32 s16, s4
  s_and_b32 s17, s5, 0xffff
  s_mov_b32 s18, 3200000
  s_mov_b32 s19, 0x00020000
  s_mov_b32 s20, s6
  s_and_b32 s21, s7, 0xffff
  s_mov_b32 s22, 3200000
  s_mov_b32 s23, 0x00020000
  s_mov_b32 s24, s8
  s_and_b32 s25, s9, 0xffff
  s_mov_b32 s26, 1600000
  s_mov_b32 s27, 0x00020000
  s_mov_b32 s28, s10
  s_and_b32 s29, s11, 0xffff
  s_mov_b32 s30, 8388608
  s_mov_b32 s31, 0x00020000
  s_mov_b32 s32, s12
  s_and_b32 s33, s13, 0xffff
  s_mov_b32 s34, 6400000
  s_mov_b32 s35, 0x00020000
  v_add_u32 v1, s3, v0
  v_lshlrev_b32 v2, 2, v1
  v_lshlrev_b32 v3, 1, v1
  s_mov_b32 s37, 4096
  s_mov_b32 s38, 8192
  s_mov_b32 s39, 12288
  s_mov_b32 s40, 2048
  s_mov_b32 s41, 6144
  buffer_load_dword v10, v2, s[20:23], 0 offen
  buffer_load_dword v14, v2, s[16:19], 0 offen
  buffer_load_ushort v18, v3, s[24:27], 0 offen
  buffer_load_dword v11, v2, s[20:23], s37 offen
  buffer_load_dword v15, v2, s[16:19], s37 offen
  buffer_load_ushort v19, v3, s[24:27], s40 offen
  buffer_load_dword v12, v2, s[20:23], s38 offen
  buffer_load_dword v16, v2, s[16:19], s38 offen
  buffer_load_ushort v20, v3, s[24:27], s37 offen
  v_cmp_gt_u32 s[44:45], 53, v0
  s_mov_b64 s[46:47], exec
  s_and_b64 exec, exec, s[44:45]
  s_cbranch_execz K1_L3SKIP
  buffer_load_dword v13, v2, s[20:23], s39 offen
  buffer_load_dword v17, v2, s[16:19], s39 offen
  buffer_load_ushort v21, v3, s[24:27], s41 offen
K1_L3SKIP:
  s_mov_b64 exec, s[46:47]
  s_lshl_b32 s42, s2, 14
  v_lshlrev_b32 v4, 4, v0
  v_add_u32 v4, s42, v4
  s_mov_b32 s43, 0x400000
  buffer_load_dwordx4 v[40:43], v4, s[32:35], 0 offen
  buffer_load_dwordx4 v[44:47], v4, s[32:35], s43 offen
  v_cmp_gt_u32 vcc, 256, v0
  s_and_saveexec_b64 s[46:47], vcc
  v_lshlrev_b32 v5, 2, v0
  v_mov_b32 v6, 0
  ds_write_b32 v5, v6
  s_mov_b64 exec, s[46:47]
  s_waitcnt lgkmcnt(0)
  s_barrier
  s_waitcnt vmcnt(2)
  s_mov_b32 s48, 21913099
  v_mov_b32 v7, 1
  v_min_u32 v10, 49999, v10
  v_min_u32 v14, 49999, v14
  v_mul_hi_u32 v22, v10, s48
  v_mul_u32_u24 v5, 196, v22
  v_sub_u32 v26, v10, v5
  v_lshlrev_b32 v5, 2, v22
  ds_add_rtn_u32 v30, v5, v7
  v_min_u32 v11, 49999, v11
  v_min_u32 v15, 49999, v15
  v_mul_hi_u32 v23, v11, s48
  v_mul_u32_u24 v5, 196, v23
  v_sub_u32 v27, v11, v5
  v_lshlrev_b32 v5, 2, v23
  ds_add_rtn_u32 v31, v5, v7
  v_min_u32 v12, 49999, v12
  v_min_u32 v16, 49999, v16
  v_mul_hi_u32 v24, v12, s48
  v_mul_u32_u24 v5, 196, v24
  v_sub_u32 v28, v12, v5
  v_lshlrev_b32 v5, 2, v24
  ds_add_rtn_u32 v32, v5, v7
  s_and_b64 exec, exec, s[44:45]
  s_cbranch_execz K1_R3SKIP
  v_min_u32 v13, 49999, v13
  v_min_u32 v17, 49999, v17
  v_mul_hi_u32 v25, v13, s48
  v_mul_u32_u24 v5, 196, v25
  v_sub_u32 v29, v13, v5
  v_lshlrev_b32 v5, 2, v25
  ds_add_rtn_u32 v33, v5, v7
K1_R3SKIP:
  s_mov_b64 exec, -1
  s_waitcnt lgkmcnt(0)
  s_barrier
  s_cmp_lg_u32 s36, 0
  s_cbranch_scc1 K1_NOSCAN
  v_lshlrev_b32 v5, 4, v0
  ds_read_b128 v[48:51], v5
  s_waitcnt lgkmcnt(0)
  v_add_u32 v52, v48, v49
  v_add_u32 v53, v52, v50
  v_add_u32 v54, v53, v51
  v_mov_b32 v55, v54
  s_nop 1
  v_add_u32_dpp v55, v55, v55 row_shr:1 row_mask:0xf bank_mask:0xf bound_ctrl:0
  s_nop 1
  v_add_u32_dpp v55, v55, v55 row_shr:2 row_mask:0xf bank_mask:0xf bound_ctrl:0
  s_nop 1
  v_add_u32_dpp v55, v55, v55 row_shr:4 row_mask:0xf bank_mask:0xf bound_ctrl:0
  s_nop 1
  v_add_u32_dpp v55, v55, v55 row_shr:8 row_mask:0xf bank_mask:0xf bound_ctrl:0
  s_nop 1
  v_add_u32_dpp v55, v55, v55 row_bcast:15 row_mask:0xa bank_mask:0xf
  s_nop 1
  v_add_u32_dpp v55, v55, v55 row_bcast:31 row_mask:0xc bank_mask:0xf
  s_nop 1
  v_sub_u32 v56, v55, v54
  v_add_u32 v57, v56, v48
  v_add_u32 v58, v56, v52
  v_add_u32 v59, v56, v53
  ds_write_b128 v5, v[56:59] offset:1024
  v_lshl_or_b32 v60, v48, 16, v56
  v_lshl_or_b32 v61, v49, 16, v57
  v_lshl_or_b32 v62, v50, 16, v58
  v_lshl_or_b32 v63, v51, 16, v59
  s_lshl_b32 s42, s2, 2
  s_add_u32 s42, s42, 7340032
  v_lshlrev_b32 v6, 12, v0
  v_add_u32 v6, s42, v6
  buffer_store_dword v60, v6, s[28:31], 0 offen offset:0
  buffer_store_dword v61, v6, s[28:31], 0 offen offset:1024
  buffer_store_dword v62, v6, s[28:31], 0 offen offset:2048
  buffer_store_dword v63, v6, s[28:31], 0 offen offset:3072
K1_NOSCAN:
  s_waitcnt lgkmcnt(0)
  s_barrier
  v_lshlrev_b32 v5, 2, v22
  ds_read_b32 v34, v5 offset:1024
  v_lshlrev_b32 v5, 2, v23
  ds_read_b32 v35, v5 offset:1024
  v_lshlrev_b32 v5, 2, v24
  ds_read_b32 v36, v5 offset:1024
  s_and_b64 exec, exec, s[44:45]
  v_lshlrev_b32 v5, 2, v25
  ds_read_b32 v37, v5 offset:1024
  s_mov_b64 exec, -1
  s_waitcnt lgkmcnt(0)
  v_add_u32 v34, v34, v30
  v_lshlrev_b32 v34, 3, v34
  v_lshl_or_b32 v8, v26, 16, v14
  v_lshlrev_b32 v9, 16, v18
  ds_write_b64 v34, v[8:9] offset:2048
  v_add_u32 v35, v35, v31
  v_lshlrev_b32 v35, 3, v35
  v_lshl_or_b32 v8, v27, 16, v15
  v_lshlrev_b32 v9, 16, v19
  ds_write_b64 v35, v[8:9] offset:2048
  v_add_u32 v36, v36, v32
  v_lshlrev_b32 v36, 3, v36
  v_lshl_or_b32 v8, v28, 16, v16
  v_lshlrev_b32 v9, 16, v20
  ds_write_b64 v36, v[8:9] offset:2048
  s_and_b64 exec, exec, s[44:45]
  v_add_u32 v37, v37, v33
  v_lshlrev_b32 v37, 3, v37
  v_lshl_or_b32 v8, v29, 16, v17
  v_lshlrev_b32 v9, 16, v21
  ds_write_b64 v37, v[8:9] offset:2048
  s_mov_b64 exec, -1
  s_waitcnt lgkmcnt(0)
  s_barrier
  v_lshlrev_b32 v5, 4, v0
  ds_read_b128 v[48:51], v5 offset:2048
  ds_read_b128 v[52:55], v5 offset:18432
  s_mul_i32 s42, s2, 25024
  v_add_u32 v6, s42, v5
  s_mov_b32 s43, 16384
  s_waitcnt lgkmcnt(0)
  buffer_store_dwordx4 v[48:51], v6, s[28:31], 0 offen
  v_cmp_gt_u32 vcc, 539, v0
  s_and_b64 exec, exec, vcc
  s_cbranch_execz K1_END
  buffer_store_dwordx4 v[52:55], v6, s[28:31], s43 offen
K1_END:
  s_endpgm

.globl spmm_agg_kernel
.p2align 8
.type spmm_agg_kernel,@function
spmm_agg_kernel:
  s_cmp_ge_u32 s2, 256
  s_cbranch_scc1 K2_END
  s_load_dwordx2 s[4:5], s[0:1], 0
  s_load_dwordx2 s[6:7], s[0:1], 32
  s_load_dwordx2 s[8:9], s[0:1], 40
  s_load_dwordx2 s[10:11], s[0:1], 56
  v_lshrrev_b32 v1, 6, v0
  s_nop 0
  v_readfirstlane_b32 s28, v1
  v_and_b32 v1, 63, v0
  v_lshrrev_b32 v2, 3, v1
  v_and_b32 v3, 7, v1
  s_waitcnt lgkmcnt(0)
  s_mov_b32 s12, s4
  s_and_b32 s13, s5, 0xffff
  s_mov_b32 s14, 6400000
  s_mov_b32 s15, 0x00020000
  s_mov_b32 s16, s6
  s_and_b32 s17, s7, 0xffff
  s_mov_b32 s18, 8192
  s_mov_b32 s19, 0x00020000
  s_mov_b32 s20, s8
  s_and_b32 s21, s9, 0xffff
  s_mov_b32 s22, 6400000
  s_mov_b32 s23, 0x00020000
  s_mov_b32 s24, s10
  s_and_b32 s25, s11, 0xffff
  s_mov_b32 s26, 8388608
  s_mov_b32 s27, 0x00020000
  s_mov_b32 s36, s10
  s_and_b32 s37, s11, 0xffff
  s_mov_b32 s38, 67108864
  s_mov_b32 s39, 0x00020000
  s_lshl_b32 s3, s2, 10
  s_add_u32 s3, s3, 7340032
  v_lshlrev_b32 v4, 2, v0
  v_add_u32 v4, s3, v4
  v_cmp_gt_u32 vcc, 256, v0
  s_mov_b64 s[32:33], vcc
  s_mov_b64 exec, s[32:33]
  buffer_load_dword v5, v4, s[24:27], 0 offen
  s_mov_b64 exec, -1
  v_lshlrev_b32 v6, 4, v0
  v_cmp_gt_u32 vcc, 512, v0
  s_mov_b64 s[34:35], vcc
  s_mov_b64 exec, s[34:35]
  buffer_load_dwordx4 v[8:11], v6, s[16:19], 0 offen
  s_mov_b64 exec, -1
  v_mov_b32 v12, 0
  v_mov_b32 v13, 0
  v_mov_b32 v14, 0
  v_mov_b32 v15, 0
  v_add_u32 v16, 45440, v6
  ds_write_b128 v16, v[12:15] offset:0
  ds_write_b128 v16, v[12:15] offset:16384
  ds_write_b128 v16, v[12:15] offset:32768
  v_cmp_gt_u32 vcc, 736, v0
  s_mov_b64 exec, vcc
  ds_write_b128 v16, v[12:15] offset:49152
  s_mov_b64 exec, -1
  s_waitcnt vmcnt(0)
  s_mov_b64 exec, s[34:35]
  ds_write_b128 v6, v[8:11] offset:0
  s_mov_b64 exec, s[32:33]
  v_lshrrev_b32 v7, 16, v5
  v_and_b32 v5, 0xffff, v5
  v_lshlrev_b32 v4, 2, v0
  ds_write_b32 v4, v7 offset:10240
  ds_write_b32 v4, v5 offset:11264
  s_mov_b64 exec, -1
  s_waitcnt lgkmcnt(0)
  s_barrier
  s_cmp_lg_u32 s28, 0
  s_cbranch_scc1 K2_NOSCAN1
  v_lshlrev_b32 v4, 4, v1
  ds_read_b128 v[8:11], v4 offset:10240
  ds_read_b128 v[16:19], v4 offset:11264
  s_waitcnt lgkmcnt(0)
  v_add_u32 v12, v8, v9
  v_add_u32 v13, v12, v10
  v_add_u32 v14, v13, v11
  v_mov_b32 v15, v14
  s_nop 1
  v_add_u32_dpp v15, v15, v15 row_shr:1 row_mask:0xf bank_mask:0xf bound_ctrl:0
  s_nop 1
  v_add_u32_dpp v15, v15, v15 row_shr:2 row_mask:0xf bank_mask:0xf bound_ctrl:0
  s_nop 1
  v_add_u32_dpp v15, v15, v15 row_shr:4 row_mask:0xf bank_mask:0xf bound_ctrl:0
  s_nop 1
  v_add_u32_dpp v15, v15, v15 row_shr:8 row_mask:0xf bank_mask:0xf bound_ctrl:0
  s_nop 1
  v_add_u32_dpp v15, v15, v15 row_bcast:15 row_mask:0xa bank_mask:0xf
  s_nop 1
  v_add_u32_dpp v15, v15, v15 row_bcast:31 row_mask:0xc bank_mask:0xf
  s_nop 1
  v_sub_u32 v20, v15, v14
  v_add_u32 v21, v20, v8
  v_add_u32 v22, v20, v12
  v_add_u32 v23, v20, v13
  ds_write_b128 v4, v[20:23] offset:10240
  v_lshlrev_b32 v24, 2, v1
  s_mov_b32 s3, 25024
  v_add_u32 v25, 0, v24
  v_mul_lo_u32 v25, v25, s3
  v_sub_u32 v26, v16, v20
  v_lshlrev_b32 v26, 3, v26
  v_add_u32 v28, v25, v26
  v_add_u32 v25, 1, v24
  v_mul_lo_u32 v25, v25, s3
  v_sub_u32 v26, v17, v21
  v_lshlrev_b32 v26, 3, v26
  v_add_u32 v29, v25, v26
  v_add_u32 v25, 2, v24
  v_mul_lo_u32 v25, v25, s3
  v_sub_u32 v26, v18, v22
  v_lshlrev_b32 v26, 3, v26
  v_add_u32 v30, v25, v26
  v_add_u32 v25, 3, v24
  v_mul_lo_u32 v25, v25, s3
  v_sub_u32 v26, v19, v23
  v_lshlrev_b32 v26, 3, v26
  v_add_u32 v31, v25, v26
  ds_write_b128 v4, v[28:31] offset:11264
  v_mov_b32 v4, 63
  v_cmp_eq_u32 vcc, v4, v1
  s_mov_b64 exec, vcc
  v_mov_b32 v4, 0
  ds_write_b32 v4, v15 offset:12288
  s_mov_b64 exec, -1
K2_NOSCAN1:
  s_waitcnt lgkmcnt(0)
  s_barrier
  v_mov_b32 v4, 0
  ds_read_b32 v5, v4 offset:12288
  s_waitcnt lgkmcnt(0)
  s_nop 0
  v_readfirstlane_b32 s29, v5
  s_mov_b32 s30, 0
  s_cmp_eq_u32 s29, 0
  s_cbranch_scc1 K2_EPI
K2_ROUND:
  v_lshlrev_b32 v4, 2, v0
  v_mov_b32 v5, 0
  s_mov_b64 exec, s[32:33]
  ds_write_b32 v4, v5 offset:8192
  s_mov_b64 exec, -1
  v_add_u32 v16, s30, v0
  v_add_u32 v17, 1024, v16
  v_add_u32 v18, 2048, v16
  v_add_u32 v19, 3072, v16
  v_cmp_gt_u32 s[40:41], s29, v16
  v_cmp_gt_u32 s[42:43], s29, v17
  v_cmp_gt_u32 s[44:45], s29, v18
  v_cmp_gt_u32 s[46:47], s29, v19
  v_mov_b32 v20, 0
  v_mov_b32 v21, 0
  v_mov_b32 v22, 0
  v_mov_b32 v23, 0
  s_waitcnt lgkmcnt(0)
  v_add_u32 v24, 128, v20
  v_lshlrev_b32 v28, 2, v24
  ds_read_b32 v28, v28 offset:10240
  v_add_u32 v25, 128, v21
  v_lshlrev_b32 v29, 2, v25
  ds_read_b32 v29, v29 offset:10240
  v_add_u32 v26, 128, v22
  v_lshlrev_b32 v30, 2, v26
  ds_read_b32 v30, v30 offset:10240
  v_add_u32 v27, 128, v23
  v_lshlrev_b32 v31, 2, v27
  ds_read_b32 v31, v31 offset:10240
  s_waitcnt lgkmcnt(0)
  v_cmp_le_u32 vcc, v28, v16
  s_nop 1
  v_cndmask_b32 v20, v20, v24, vcc
  v_cmp_le_u32 vcc, v29, v17
  s_nop 1
  v_cndmask_b32 v21, v21, v25, vcc
  v_cmp_le_u32 vcc, v30, v18
  s_nop 1
  v_cndmask_b32 v22, v22, v26, vcc
  v_cmp_le_u32 vcc, v31, v19
  s_nop 1
  v_cndmask_b32 v23, v23, v27, vcc
  v_add_u32 v24, 64, v20
  v_lshlrev_b32 v28, 2, v24
  ds_read_b32 v28, v28 offset:10240
  v_add_u32 v25, 64, v21
  v_lshlrev_b32 v29, 2, v25
  ds_read_b32 v29, v29 offset:10240
  v_add_u32 v26, 64, v22
  v_lshlrev_b32 v30, 2, v26
  ds_read_b32 v30, v30 offset:10240
  v_add_u32 v27, 64, v23
  v_lshlrev_b32 v31, 2, v27
  ds_read_b32 v31, v31 offset:10240
  s_waitcnt lgkmcnt(0)
  v_cmp_le_u32 vcc, v28, v16
  s_nop 1
  v_cndmask_b32 v20, v20, v24, vcc
  v_cmp_le_u32 vcc, v29, v17
  s_nop 1
  v_cndmask_b32 v21, v21, v25, vcc
  v_cmp_le_u32 vcc, v30, v18
  s_nop 1
  v_cndmask_b32 v22, v22, v26, vcc
  v_cmp_le_u32 vcc, v31, v19
  s_nop 1
  v_cndmask_b32 v23, v23, v27, vcc
  v_add_u32 v24, 32, v20
  v_lshlrev_b32 v28, 2, v24
  ds_read_b32 v28, v28 offset:10240
  v_add_u32 v25, 32, v21
  v_lshlrev_b32 v29, 2, v25
  ds_read_b32 v29, v29 offset:10240
  v_add_u32 v26, 32, v22
  v_lshlrev_b32 v30, 2, v26
  ds_read_b32 v30, v30 offset:10240
  v_add_u32 v27, 32, v23
  v_lshlrev_b32 v31, 2, v27
  ds_read_b32 v31, v31 offset:10240
  s_waitcnt lgkmcnt(0)
  v_cmp_le_u32 vcc, v28, v16
  s_nop 1
  v_cndmask_b32 v20, v20, v24, vcc
  v_cmp_le_u32 vcc, v29, v17
  s_nop 1
  v_cndmask_b32 v21, v21, v25, vcc
  v_cmp_le_u32 vcc, v30, v18
  s_nop 1
  v_cndmask_b32 v22, v22, v26, vcc
  v_cmp_le_u32 vcc, v31, v19
  s_nop 1
  v_cndmask_b32 v23, v23, v27, vcc
  v_add_u32 v24, 16, v20
  v_lshlrev_b32 v28, 2, v24
  ds_read_b32 v28, v28 offset:10240
  v_add_u32 v25, 16, v21
  v_lshlrev_b32 v29, 2, v25
  ds_read_b32 v29, v29 offset:10240
  v_add_u32 v26, 16, v22
  v_lshlrev_b32 v30, 2, v26
  ds_read_b32 v30, v30 offset:10240
  v_add_u32 v27, 16, v23
  v_lshlrev_b32 v31, 2, v27
  ds_read_b32 v31, v31 offset:10240
  s_waitcnt lgkmcnt(0)
  v_cmp_le_u32 vcc, v28, v16
  s_nop 1
  v_cndmask_b32 v20, v20, v24, vcc
  v_cmp_le_u32 vcc, v29, v17
  s_nop 1
  v_cndmask_b32 v21, v21, v25, vcc
  v_cmp_le_u32 vcc, v30, v18
  s_nop 1
  v_cndmask_b32 v22, v22, v26, vcc
  v_cmp_le_u32 vcc, v31, v19
  s_nop 1
  v_cndmask_b32 v23, v23, v27, vcc
  v_add_u32 v24, 8, v20
  v_lshlrev_b32 v28, 2, v24
  ds_read_b32 v28, v28 offset:10240
  v_add_u32 v25, 8, v21
  v_lshlrev_b32 v29, 2, v25
  ds_read_b32 v29, v29 offset:10240
  v_add_u32 v26, 8, v22
  v_lshlrev_b32 v30, 2, v26
  ds_read_b32 v30, v30 offset:10240
  v_add_u32 v27, 8, v23
  v_lshlrev_b32 v31, 2, v27
  ds_read_b32 v31, v31 offset:10240
  s_waitcnt lgkmcnt(0)
  v_cmp_le_u32 vcc, v28, v16
  s_nop 1
  v_cndmask_b32 v20, v20, v24, vcc
  v_cmp_le_u32 vcc, v29, v17
  s_nop 1
  v_cndmask_b32 v21, v21, v25, vcc
  v_cmp_le_u32 vcc, v30, v18
  s_nop 1
  v_cndmask_b32 v22, v22, v26, vcc
  v_cmp_le_u32 vcc, v31, v19
  s_nop 1
  v_cndmask_b32 v23, v23, v27, vcc
  v_add_u32 v24, 4, v20
  v_lshlrev_b32 v28, 2, v24
  ds_read_b32 v28, v28 offset:10240
  v_add_u32 v25, 4, v21
  v_lshlrev_b32 v29, 2, v25
  ds_read_b32 v29, v29 offset:10240
  v_add_u32 v26, 4, v22
  v_lshlrev_b32 v30, 2, v26
  ds_read_b32 v30, v30 offset:10240
  v_add_u32 v27, 4, v23
  v_lshlrev_b32 v31, 2, v27
  ds_read_b32 v31, v31 offset:10240
  s_waitcnt lgkmcnt(0)
  v_cmp_le_u32 vcc, v28, v16
  s_nop 1
  v_cndmask_b32 v20, v20, v24, vcc
  v_cmp_le_u32 vcc, v29, v17
  s_nop 1
  v_cndmask_b32 v21, v21, v25, vcc
  v_cmp_le_u32 vcc, v30, v18
  s_nop 1
  v_cndmask_b32 v22, v22, v26, vcc
  v_cmp_le_u32 vcc, v31, v19
  s_nop 1
  v_cndmask_b32 v23, v23, v27, vcc
  v_add_u32 v24, 2, v20
  v_lshlrev_b32 v28, 2, v24
  ds_read_b32 v28, v28 offset:10240
  v_add_u32 v25, 2, v21
  v_lshlrev_b32 v29, 2, v25
  ds_read_b32 v29, v29 offset:10240
  v_add_u32 v26, 2, v22
  v_lshlrev_b32 v30, 2, v26
  ds_read_b32 v30, v30 offset:10240
  v_add_u32 v27, 2, v23
  v_lshlrev_b32 v31, 2, v27
  ds_read_b32 v31, v31 offset:10240
  s_waitcnt lgkmcnt(0)
  v_cmp_le_u32 vcc, v28, v16
  s_nop 1
  v_cndmask_b32 v20, v20, v24, vcc
  v_cmp_le_u32 vcc, v29, v17
  s_nop 1
  v_cndmask_b32 v21, v21, v25, vcc
  v_cmp_le_u32 vcc, v30, v18
  s_nop 1
  v_cndmask_b32 v22, v22, v26, vcc
  v_cmp_le_u32 vcc, v31, v19
  s_nop 1
  v_cndmask_b32 v23, v23, v27, vcc
  v_add_u32 v24, 1, v20
  v_lshlrev_b32 v28, 2, v24
  ds_read_b32 v28, v28 offset:10240
  v_add_u32 v25, 1, v21
  v_lshlrev_b32 v29, 2, v25
  ds_read_b32 v29, v29 offset:10240
  v_add_u32 v26, 1, v22
  v_lshlrev_b32 v30, 2, v26
  ds_read_b32 v30, v30 offset:10240
  v_add_u32 v27, 1, v23
  v_lshlrev_b32 v31, 2, v27
  ds_read_b32 v31, v31 offset:10240
  s_waitcnt lgkmcnt(0)
  v_cmp_le_u32 vcc, v28, v16
  s_nop 1
  v_cndmask_b32 v20, v20, v24, vcc
  v_cmp_le_u32 vcc, v29, v17
  s_nop 1
  v_cndmask_b32 v21, v21, v25, vcc
  v_cmp_le_u32 vcc, v30, v18
  s_nop 1
  v_cndmask_b32 v22, v22, v26, vcc
  v_cmp_le_u32 vcc, v31, v19
  s_nop 1
  v_cndmask_b32 v23, v23, v27, vcc
  v_lshlrev_b32 v28, 2, v20
  ds_read_b32 v28, v28 offset:11264
  v_lshlrev_b32 v29, 2, v21
  ds_read_b32 v29, v29 offset:11264
  v_lshlrev_b32 v30, 2, v22
  ds_read_b32 v30, v30 offset:11264
  v_lshlrev_b32 v31, 2, v23
  ds_read_b32 v31, v31 offset:11264
  s_waitcnt lgkmcnt(0)
  v_lshlrev_b32 v24, 3, v16
  v_add_u32 v24, v24, v28
  s_mov_b64 exec, s[40:41]
  buffer_load_dwordx2 v[32:33], v24, s[24:27], 0 offen
  v_lshlrev_b32 v25, 3, v17
  v_add_u32 v25, v25, v29
  s_mov_b64 exec, s[42:43]
  buffer_load_dwordx2 v[34:35], v25, s[24:27], 0 offen
  v_lshlrev_b32 v26, 3, v18
  v_add_u32 v26, v26, v30
  s_mov_b64 exec, s[44:45]
  buffer_load_dwordx2 v[36:37], v26, s[24:27], 0 offen
  v_lshlrev_b32 v27, 3, v19
  v_add_u32 v27, v27, v31
  s_mov_b64 exec, s[46:47]
  buffer_load_dwordx2 v[38:39], v27, s[24:27], 0 offen
  s_mov_b64 exec, -1
  s_barrier
  s_waitcnt vmcnt(0)
  v_mov_b32 v7, 1
  s_mov_b64 exec, s[40:41]
  v_lshrrev_b32 v24, 16, v32
  v_lshlrev_b32 v24, 2, v24
  ds_add_rtn_u32 v28, v24, v7 offset:8192
  s_mov_b64 exec, s[42:43]
  v_lshrrev_b32 v25, 16, v34
  v_lshlrev_b32 v25, 2, v25
  ds_add_rtn_u32 v29, v25, v7 offset:8192
  s_mov_b64 exec, s[44:45]
  v_lshrrev_b32 v26, 16, v36
  v_lshlrev_b32 v26, 2, v26
  ds_add_rtn_u32 v30, v26, v7 offset:8192
  s_mov_b64 exec, s[46:47]
  v_lshrrev_b32 v27, 16, v38
  v_lshlrev_b32 v27, 2, v27
  ds_add_rtn_u32 v31, v27, v7 offset:8192
  s_mov_b64 exec, -1
  s_waitcnt lgkmcnt(0)
  s_barrier
  s_cmp_lg_u32 s28, 0
  s_cbranch_scc1 K2_NOSCAN2
  v_lshlrev_b32 v4, 4, v1
  ds_read_b128 v[8:11], v4 offset:8192
  s_waitcnt lgkmcnt(0)
  v_add_u32 v12, v8, v9
  v_add_u32 v13, v12, v10
  v_add_u32 v14, v13, v11
  v_mov_b32 v15, v14
  s_nop 1
  v_add_u32_dpp v15, v15, v15 row_shr:1 row_mask:0xf bank_mask:0xf bound_ctrl:0
  s_nop 1
  v_add_u32_dpp v15, v15, v15 row_shr:2 row_mask:0xf bank_mask:0xf bound_ctrl:0
  s_nop 1
  v_add_u32_dpp v15, v15, v15 row_shr:4 row_mask:0xf bank_mask:0xf bound_ctrl:0
  s_nop 1
  v_add_u32_dpp v15, v15, v15 row_shr:8 row_mask:0xf bank_mask:0xf bound_ctrl:0
  s_nop 1
  v_add_u32_dpp v15, v15, v15 row_bcast:15 row_mask:0xa bank_mask:0xf
  s_nop 1
  v_add_u32_dpp v15, v15, v15 row_bcast:31 row_mask:0xc bank_mask:0xf
  s_nop 1
  v_sub_u32 v40, v15, v14
  v_add_u32 v41, v40, v8
  v_add_u32 v42, v40, v12
  v_add_u32 v43, v40, v13
  ds_write_b128 v4, v[40:43] offset:9216
K2_NOSCAN2:
  s_waitcnt lgkmcnt(0)
  s_barrier
  s_mov_b64 exec, s[40:41]
  ds_read_b32 v8, v24 offset:9216
  s_mov_b64 exec, s[42:43]
  ds_read_b32 v9, v25 offset:9216
  s_mov_b64 exec, s[44:45]
  ds_read_b32 v10, v26 offset:9216
  s_mov_b64 exec, s[46:47]
  ds_read_b32 v11, v27 offset:9216
  s_mov_b64 exec, -1
  s_waitcnt lgkmcnt(0)
  s_mov_b64 exec, s[40:41]
  v_add_u32 v8, v8, v28
  v_lshlrev_b32 v8, 3, v8
  v_and_b32 v32, 0xffff, v32
  v_lshlrev_b32 v32, 7, v32
  ds_write_b64 v8, v[32:33] offset:12544
  s_mov_b64 exec, s[42:43]
  v_add_u32 v9, v9, v29
  v_lshlrev_b32 v9, 3, v9
  v_and_b32 v34, 0xffff, v34
  v_lshlrev_b32 v34, 7, v34
  ds_write_b64 v9, v[34:35] offset:12544
  s_mov_b64 exec, s[44:45]
  v_add_u32 v10, v10, v30
  v_lshlrev_b32 v10, 3, v10
  v_and_b32 v36, 0xffff, v36
  v_lshlrev_b32 v36, 7, v36
  ds_write_b64 v10, v[36:37] offset:12544
  s_mov_b64 exec, s[46:47]
  v_add_u32 v11, v11, v31
  v_lshlrev_b32 v11, 3, v11
  v_and_b32 v38, 0xffff, v38
  v_lshlrev_b32 v38, 7, v38
  ds_write_b64 v11, v[38:39] offset:12544
  s_mov_b64 exec, -1
  s_waitcnt lgkmcnt(0)
  s_barrier
  v_lshlrev_b32 v60, 4, v3
  s_mov_b32 s31, s28
K2_OCT:
  s_cmp_ge_u32 s31, 25
  s_cbranch_scc1 K2_MAINDONE
  s_lshl_b32 s3, s31, 3
  v_add_u32 v4, s3, v2
  v_lshlrev_b32 v5, 2, v4
  ds_read_b32 v6, v5 offset:9216
  ds_read_b32 v7, v5 offset:8192
  v_mov_b32 v8, 0
  v_mov_b32 v9, 0
  v_mov_b32 v10, 0
  v_mov_b32 v11, 0
  v_mov_b32 v12, 0
  v_mov_b32 v13, 0
  v_mov_b32 v14, 0
  v_mov_b32 v15, 0
  s_waitcnt lgkmcnt(0)
  v_add_u32 v7, v6, v7
K2_IT:
  v_cmp_lt_u32 vcc, v6, v7
  s_cbranch_vccz K2_FLUSH
  v_lshlrev_b32 v5, 3, v6
  ds_read_b64 v[20:21], v5 offset:12544
  ds_read_b64 v[22:23], v5 offset:12552
  ds_read_b64 v[24:25], v5 offset:12560
  ds_read_b64 v[26:27], v5 offset:12568
  ds_read_b64 v[28:29], v5 offset:12576
  ds_read_b64 v[30:31], v5 offset:12584
  ds_read_b64 v[32:33], v5 offset:12592
  ds_read_b64 v[34:35], v5 offset:12600
  v_add_u32 v16, 0, v6
  v_cmp_lt_u32 s[40:41], v16, v7
  v_add_u32 v16, 1, v6
  v_cmp_lt_u32 s[42:43], v16, v7
  v_add_u32 v16, 2, v6
  v_cmp_lt_u32 s[44:45], v16, v7
  v_add_u32 v16, 3, v6
  v_cmp_lt_u32 s[46:47], v16, v7
  v_add_u32 v16, 4, v6
  v_cmp_lt_u32 s[48:49], v16, v7
  v_add_u32 v16, 5, v6
  v_cmp_lt_u32 s[50:51], v16, v7
  v_add_u32 v16, 6, v6
  v_cmp_lt_u32 s[52:53], v16, v7
  v_add_u32 v16, 7, v6
  v_cmp_lt_u32 s[54:55], v16, v7
  s_waitcnt lgkmcnt(0)
  v_add_u32 v20, v20, v60
  s_mov_b64 exec, s[40:41]
  buffer_load_dwordx4 v[64:67], v20, s[12:15], 0 offen
  v_add_u32 v22, v22, v60
  s_mov_b64 exec, s[42:43]
  buffer_load_dwordx4 v[68:71], v22, s[12:15], 0 offen
  v_add_u32 v24, v24, v60
  s_mov_b64 exec, s[44:45]
  buffer_load_dwordx4 v[72:75], v24, s[12:15], 0 offen
  v_add_u32 v26, v26, v60
  s_mov_b64 exec, s[46:47]
  buffer_load_dwordx4 v[76:79], v26, s[12:15], 0 offen
  v_add_u32 v28, v28, v60
  s_mov_b64 exec, s[48:49]
  buffer_load_dwordx4 v[80:83], v28, s[12:15], 0 offen
  v_add_u32 v30, v30, v60
  s_mov_b64 exec, s[50:51]
  buffer_load_dwordx4 v[84:87], v30, s[12:15], 0 offen
  v_add_u32 v32, v32, v60
  s_mov_b64 exec, s[52:53]
  buffer_load_dwordx4 v[88:91], v32, s[12:15], 0 offen
  v_add_u32 v34, v34, v60
  s_mov_b64 exec, s[54:55]
  buffer_load_dwordx4 v[92:95], v34, s[12:15], 0 offen
  s_mov_b64 exec, s[40:41]
  s_waitcnt vmcnt(7)
  v_lshlrev_b32 v16, 16, v64
  v_and_b32 v17, 0xffff0000, v64
  v_fmac_f32 v8, v16, v21
  v_fmac_f32 v9, v17, v21
  v_lshlrev_b32 v16, 16, v65
  v_and_b32 v17, 0xffff0000, v65
  v_fmac_f32 v10, v16, v21
  v_fmac_f32 v11, v17, v21
  v_lshlrev_b32 v16, 16, v66
  v_and_b32 v17, 0xffff0000, v66
  v_fmac_f32 v12, v16, v21
  v_fmac_f32 v13, v17, v21
  v_lshlrev_b32 v16, 16, v67
  v_and_b32 v17, 0xffff0000, v67
  v_fmac_f32 v14, v16, v21
  v_fmac_f32 v15, v17, v21
  s_mov_b64 exec, s[42:43]
  s_waitcnt vmcnt(6)
  v_lshlrev_b32 v16, 16, v68
  v_and_b32 v17, 0xffff0000, v68
  v_fmac_f32 v8, v16, v23
  v_fmac_f32 v9, v17, v23
  v_lshlrev_b32 v16, 16, v69
  v_and_b32 v17, 0xffff0000, v69
  v_fmac_f32 v10, v16, v23
  v_fmac_f32 v11, v17, v23
  v_lshlrev_b32 v16, 16, v70
  v_and_b32 v17, 0xffff0000, v70
  v_fmac_f32 v12, v16, v23
  v_fmac_f32 v13, v17, v23
  v_lshlrev_b32 v16, 16, v71
  v_and_b32 v17, 0xffff0000, v71
  v_fmac_f32 v14, v16, v23
  v_fmac_f32 v15, v17, v23
  s_mov_b64 exec, s[44:45]
  s_waitcnt vmcnt(5)
  v_lshlrev_b32 v16, 16, v72
  v_and_b32 v17, 0xffff0000, v72
  v_fmac_f32 v8, v16, v25
  v_fmac_f32 v9, v17, v25
  v_lshlrev_b32 v16, 16, v73
  v_and_b32 v17, 0xffff0000, v73
  v_fmac_f32 v10, v16, v25
  v_fmac_f32 v11, v17, v25
  v_lshlrev_b32 v16, 16, v74
  v_and_b32 v17, 0xffff0000, v74
  v_fmac_f32 v12, v16, v25
  v_fmac_f32 v13, v17, v25
  v_lshlrev_b32 v16, 16, v75
  v_and_b32 v17, 0xffff0000, v75
  v_fmac_f32 v14, v16, v25
  v_fmac_f32 v15, v17, v25
  s_mov_b64 exec, s[46:47]
  s_waitcnt vmcnt(4)
  v_lshlrev_b32 v16, 16, v76
  v_and_b32 v17, 0xffff0000, v76
  v_fmac_f32 v8, v16, v27
  v_fmac_f32 v9, v17, v27
  v_lshlrev_b32 v16, 16, v77
  v_and_b32 v17, 0xffff0000, v77
  v_fmac_f32 v10, v16, v27
  v_fmac_f32 v11, v17, v27
  v_lshlrev_b32 v16, 16, v78
  v_and_b32 v17, 0xffff0000, v78
  v_fmac_f32 v12, v16, v27
  v_fmac_f32 v13, v17, v27
  v_lshlrev_b32 v16, 16, v79
  v_and_b32 v17, 0xffff0000, v79
  v_fmac_f32 v14, v16, v27
  v_fmac_f32 v15, v17, v27
  s_mov_b64 exec, s[48:49]
  s_waitcnt vmcnt(3)
  v_lshlrev_b32 v16, 16, v80
  v_and_b32 v17, 0xffff0000, v80
  v_fmac_f32 v8, v16, v29
  v_fmac_f32 v9, v17, v29
  v_lshlrev_b32 v16, 16, v81
  v_and_b32 v17, 0xffff0000, v81
  v_fmac_f32 v10, v16, v29
  v_fmac_f32 v11, v17, v29
  v_lshlrev_b32 v16, 16, v82
  v_and_b32 v17, 0xffff0000, v82
  v_fmac_f32 v12, v16, v29
  v_fmac_f32 v13, v17, v29
  v_lshlrev_b32 v16, 16, v83
  v_and_b32 v17, 0xffff0000, v83
  v_fmac_f32 v14, v16, v29
  v_fmac_f32 v15, v17, v29
  s_mov_b64 exec, s[50:51]
  s_waitcnt vmcnt(2)
  v_lshlrev_b32 v16, 16, v84
  v_and_b32 v17, 0xffff0000, v84
  v_fmac_f32 v8, v16, v31
  v_fmac_f32 v9, v17, v31
  v_lshlrev_b32 v16, 16, v85
  v_and_b32 v17, 0xffff0000, v85
  v_fmac_f32 v10, v16, v31
  v_fmac_f32 v11, v17, v31
  v_lshlrev_b32 v16, 16, v86
  v_and_b32 v17, 0xffff0000, v86
  v_fmac_f32 v12, v16, v31
  v_fmac_f32 v13, v17, v31
  v_lshlrev_b32 v16, 16, v87
  v_and_b32 v17, 0xffff0000, v87
  v_fmac_f32 v14, v16, v31
  v_fmac_f32 v15, v17, v31
  s_mov_b64 exec, s[52:53]
  s_waitcnt vmcnt(1)
  v_lshlrev_b32 v16, 16, v88
  v_and_b32 v17, 0xffff0000, v88
  v_fmac_f32 v8, v16, v33
  v_fmac_f32 v9, v17, v33
  v_lshlrev_b32 v16, 16, v89
  v_and_b32 v17, 0xffff0000, v89
  v_fmac_f32 v10, v16, v33
  v_fmac_f32 v11, v17, v33
  v_lshlrev_b32 v16, 16, v90
  v_and_b32 v17, 0xffff0000, v90
  v_fmac_f32 v12, v16, v33
  v_fmac_f32 v13, v17, v33
  v_lshlrev_b32 v16, 16, v91
  v_and_b32 v17, 0xffff0000, v91
  v_fmac_f32 v14, v16, v33
  v_fmac_f32 v15, v17, v33
  s_mov_b64 exec, s[54:55]
  s_waitcnt vmcnt(0)
  v_lshlrev_b32 v16, 16, v92
  v_and_b32 v17, 0xffff0000, v92
  v_fmac_f32 v8, v16, v35
  v_fmac_f32 v9, v17, v35
  v_lshlrev_b32 v16, 16, v93
  v_and_b32 v17, 0xffff0000, v93
  v_fmac_f32 v10, v16, v35
  v_fmac_f32 v11, v17, v35
  v_lshlrev_b32 v16, 16, v94
  v_and_b32 v17, 0xffff0000, v94
  v_fmac_f32 v12, v16, v35
  v_fmac_f32 v13, v17, v35
  v_lshlrev_b32 v16, 16, v95
  v_and_b32 v17, 0xffff0000, v95
  v_fmac_f32 v14, v16, v35
  v_fmac_f32 v15, v17, v35
  s_mov_b64 exec, -1
  v_add_u32 v6, 8, v6
  s_branch K2_IT
K2_FLUSH:
  v_mul_u32_u24 v5, 272, v4
  v_lshlrev_b32 v16, 5, v3
  v_add_u32 v5, v5, v16
  v_add_u32 v5, 45440, v5
  ds_read_b128 v[20:23], v5
  ds_read_b128 v[24:27], v5 offset:16
  s_waitcnt lgkmcnt(0)
  v_add_f32 v20, v20, v8
  v_add_f32 v21, v21, v9
  v_add_f32 v22, v22, v10
  v_add_f32 v23, v23, v11
  v_add_f32 v24, v24, v12
  v_add_f32 v25, v25, v13
  v_add_f32 v26, v26, v14
  v_add_f32 v27, v27, v15
  ds_write_b128 v5, v[20:23]
  ds_write_b128 v5, v[24:27] offset:16
  s_add_u32 s31, s31, 16
  s_branch K2_OCT
K2_MAINDONE:
  s_waitcnt lgkmcnt(0)
  s_barrier
  s_add_u32 s30, s30, 4096
  s_cmp_lt_u32 s30, s29
  s_cbranch_scc1 K2_ROUND
K2_EPI:
  s_cmp_ge_u32 s28, 7
  s_cbranch_scc1 K2_END
  v_and_b32 v4, 15, v1
  v_lshrrev_b32 v5, 4, v1
  v_lshlrev_b32 v6, 10, v5
  v_lshl_add_u32 v6, v4, 1, v6
  ds_read_u16 v16, v6 offset:0
  ds_read_u16 v17, v6 offset:128
  ds_read_u16 v18, v6 offset:256
  ds_read_u16 v19, v6 offset:384
  ds_read_u16 v20, v6 offset:512
  ds_read_u16 v21, v6 offset:640
  ds_read_u16 v22, v6 offset:768
  ds_read_u16 v23, v6 offset:896
  s_waitcnt lgkmcnt(0)
  v_lshl_or_b32 v64, v17, 16, v16
  v_lshl_or_b32 v65, v19, 16, v18
  v_lshl_or_b32 v66, v21, 16, v20
  v_lshl_or_b32 v67, v23, 16, v22
  ds_read_u16 v16, v6 offset:4096
  ds_read_u16 v17, v6 offset:4224
  ds_read_u16 v18, v6 offset:4352
  ds_read_u16 v19, v6 offset:4480
  ds_read_u16 v20, v6 offset:4608
  ds_read_u16 v21, v6 offset:4736
  ds_read_u16 v22, v6 offset:4864
  ds_read_u16 v23, v6 offset:4992
  s_waitcnt lgkmcnt(0)
  v_lshl_or_b32 v68, v17, 16, v16
  v_lshl_or_b32 v69, v19, 16, v18
  v_lshl_or_b32 v70, v21, 16, v20
  v_lshl_or_b32 v71, v23, 16, v22
  ds_read_u16 v16, v6 offset:32
  ds_read_u16 v17, v6 offset:160
  ds_read_u16 v18, v6 offset:288
  ds_read_u16 v19, v6 offset:416
  ds_read_u16 v20, v6 offset:544
  ds_read_u16 v21, v6 offset:672
  ds_read_u16 v22, v6 offset:800
  ds_read_u16 v23, v6 offset:928
  s_waitcnt lgkmcnt(0)
  v_lshl_or_b32 v72, v17, 16, v16
  v_lshl_or_b32 v73, v19, 16, v18
  v_lshl_or_b32 v74, v21, 16, v20
  v_lshl_or_b32 v75, v23, 16, v22
  ds_read_u16 v16, v6 offset:4128
  ds_read_u16 v17, v6 offset:4256
  ds_read_u16 v18, v6 offset:4384
  ds_read_u16 v19, v6 offset:4512
  ds_read_u16 v20, v6 offset:4640
  ds_read_u16 v21, v6 offset:4768
  ds_read_u16 v22, v6 offset:4896
  ds_read_u16 v23, v6 offset:5024
  s_waitcnt lgkmcnt(0)
  v_lshl_or_b32 v76, v17, 16, v16
  v_lshl_or_b32 v77, v19, 16, v18
  v_lshl_or_b32 v78, v21, 16, v20
  v_lshl_or_b32 v79, v23, 16, v22
  ds_read_u16 v16, v6 offset:64
  ds_read_u16 v17, v6 offset:192
  ds_read_u16 v18, v6 offset:320
  ds_read_u16 v19, v6 offset:448
  ds_read_u16 v20, v6 offset:576
  ds_read_u16 v21, v6 offset:704
  ds_read_u16 v22, v6 offset:832
  ds_read_u16 v23, v6 offset:960
  s_waitcnt lgkmcnt(0)
  v_lshl_or_b32 v80, v17, 16, v16
  v_lshl_or_b32 v81, v19, 16, v18
  v_lshl_or_b32 v82, v21, 16, v20
  v_lshl_or_b32 v83, v23, 16, v22
  ds_read_u16 v16, v6 offset:4160
  ds_read_u16 v17, v6 offset:4288
  ds_read_u16 v18, v6 offset:4416
  ds_read_u16 v19, v6 offset:4544
  ds_read_u16 v20, v6 offset:4672
  ds_read_u16 v21, v6 offset:4800
  ds_read_u16 v22, v6 offset:4928
  ds_read_u16 v23, v6 offset:5056
  s_waitcnt lgkmcnt(0)
  v_lshl_or_b32 v84, v17, 16, v16
  v_lshl_or_b32 v85, v19, 16, v18
  v_lshl_or_b32 v86, v21, 16, v20
  v_lshl_or_b32 v87, v23, 16, v22
  ds_read_u16 v16, v6 offset:96
  ds_read_u16 v17, v6 offset:224
  ds_read_u16 v18, v6 offset:352
  ds_read_u16 v19, v6 offset:480
  ds_read_u16 v20, v6 offset:608
  ds_read_u16 v21, v6 offset:736
  ds_read_u16 v22, v6 offset:864
  ds_read_u16 v23, v6 offset:992
  s_waitcnt lgkmcnt(0)
  v_lshl_or_b32 v88, v17, 16, v16
  v_lshl_or_b32 v89, v19, 16, v18
  v_lshl_or_b32 v90, v21, 16, v20
  v_lshl_or_b32 v91, v23, 16, v22
  ds_read_u16 v16, v6 offset:4192
  ds_read_u16 v17, v6 offset:4320
  ds_read_u16 v18, v6 offset:4448
  ds_read_u16 v19, v6 offset:4576
  ds_read_u16 v20, v6 offset:4704
  ds_read_u16 v21, v6 offset:4832
  ds_read_u16 v22, v6 offset:4960
  ds_read_u16 v23, v6 offset:5088
  s_waitcnt lgkmcnt(0)
  v_lshl_or_b32 v92, v17, 16, v16
  v_lshl_or_b32 v93, v19, 16, v18
  v_lshl_or_b32 v94, v21, 16, v20
  v_lshl_or_b32 v95, v23, 16, v22
  s_lshl_b32 s3, s28, 5
  v_add_u32 v7, s3, v4
  v_mul_u32_u24 v6, 272, v7
  v_lshlrev_b32 v8, 5, v5
  v_add_u32 v6, v6, v8
  v_add_u32 v6, 45440, v6
  ds_read_b128 v[16:19], v6 offset:0
  ds_read_b128 v[20:23], v6 offset:16
  ds_read_b128 v[24:27], v6 offset:128
  ds_read_b128 v[28:31], v6 offset:144
  v_add_u32 v7, s3, v4
  v_add_u32 v7, 16, v7
  v_mul_u32_u24 v6, 272, v7
  v_lshlrev_b32 v8, 5, v5
  v_add_u32 v6, v6, v8
  v_add_u32 v6, 45440, v6
  ds_read_b128 v[32:35], v6 offset:0
  ds_read_b128 v[36:39], v6 offset:16
  ds_read_b128 v[40:43], v6 offset:128
  ds_read_b128 v[44:47], v6 offset:144
  s_waitcnt lgkmcnt(0)
  v_cvt_pk_bf16_f32 v48, v16, v17
  v_cvt_pk_bf16_f32 v49, v18, v19
  v_cvt_pk_bf16_f32 v50, v20, v21
  v_cvt_pk_bf16_f32 v51, v22, v23
  v_cvt_pk_bf16_f32 v52, v24, v25
  v_cvt_pk_bf16_f32 v53, v26, v27
  v_cvt_pk_bf16_f32 v54, v28, v29
  v_cvt_pk_bf16_f32 v55, v30, v31
  v_cvt_pk_bf16_f32 v56, v32, v33
  v_cvt_pk_bf16_f32 v57, v34, v35
  v_cvt_pk_bf16_f32 v58, v36, v37
  v_cvt_pk_bf16_f32 v59, v38, v39
  v_cvt_pk_bf16_f32 v60, v40, v41
  v_cvt_pk_bf16_f32 v61, v42, v43
  v_cvt_pk_bf16_f32 v62, v44, v45
  v_cvt_pk_bf16_f32 v63, v46, v47
  s_nop 1
  v_mfma_f32_16x16x32_bf16 v[96:99], v[64:67], v[48:51], 0
  v_mfma_f32_16x16x32_bf16 v[96:99], v[68:71], v[52:55], v[96:99]
  v_mfma_f32_16x16x32_bf16 v[100:103], v[72:75], v[48:51], 0
  v_mfma_f32_16x16x32_bf16 v[100:103], v[76:79], v[52:55], v[100:103]
  v_mfma_f32_16x16x32_bf16 v[104:107], v[80:83], v[48:51], 0
  v_mfma_f32_16x16x32_bf16 v[104:107], v[84:87], v[52:55], v[104:107]
  v_mfma_f32_16x16x32_bf16 v[108:111], v[88:91], v[48:51], 0
  v_mfma_f32_16x16x32_bf16 v[108:111], v[92:95], v[52:55], v[108:111]
  v_mfma_f32_16x16x32_bf16 v[112:115], v[64:67], v[56:59], 0
  v_mfma_f32_16x16x32_bf16 v[112:115], v[68:71], v[60:63], v[112:115]
  v_mfma_f32_16x16x32_bf16 v[116:119], v[72:75], v[56:59], 0
  v_mfma_f32_16x16x32_bf16 v[116:119], v[76:79], v[60:63], v[116:119]
  v_mfma_f32_16x16x32_bf16 v[120:123], v[80:83], v[56:59], 0
  v_mfma_f32_16x16x32_bf16 v[120:123], v[84:87], v[60:63], v[120:123]
  v_mfma_f32_16x16x32_bf16 v[124:127], v[88:91], v[56:59], 0
  v_mfma_f32_16x16x32_bf16 v[124:127], v[92:95], v[60:63], v[124:127]
  s_nop 15
  s_nop 3
  s_mul_i32 s3, s2, 196
  v_cvt_pk_bf16_f32 v16, v96, v97
  v_cvt_pk_bf16_f32 v17, v98, v99
  v_cvt_pk_bf16_f32 v18, v100, v101
  v_cvt_pk_bf16_f32 v19, v102, v103
  v_cvt_pk_bf16_f32 v20, v104, v105
  v_cvt_pk_bf16_f32 v21, v106, v107
  v_cvt_pk_bf16_f32 v22, v108, v109
  v_cvt_pk_bf16_f32 v23, v110, v111
  v_cvt_pk_bf16_f32 v24, v112, v113
  v_cvt_pk_bf16_f32 v25, v114, v115
  v_cvt_pk_bf16_f32 v26, v116, v117
  v_cvt_pk_bf16_f32 v27, v118, v119
  v_cvt_pk_bf16_f32 v28, v120, v121
  v_cvt_pk_bf16_f32 v29, v122, v123
  v_cvt_pk_bf16_f32 v30, v124, v125
  v_cvt_pk_bf16_f32 v31, v126, v127
  v_add_u32 v7, s3, v4
  s_lshl_b32 s37, s28, 5
  v_add_u32 v7, s37, v7
  v_lshlrev_b32 v8, 7, v7
  v_lshl_add_u32 v8, v5, 3, v8
  v_sub_u32 v9, v7, s3
  v_cmp_gt_u32 vcc, 196, v9
  s_mov_b64 exec, vcc
  buffer_store_dwordx2 v[16:17], v8, s[20:23], 0 offen offset:0
  buffer_store_dwordx2 v[18:19], v8, s[20:23], 0 offen offset:32
  buffer_store_dwordx2 v[20:21], v8, s[20:23], 0 offen offset:64
  buffer_store_dwordx2 v[22:23], v8, s[20:23], 0 offen offset:96
  s_mov_b64 exec, -1
  v_add_u32 v7, s3, v4
  s_lshl_b32 s37, s28, 5
  v_add_u32 v7, s37, v7
  v_add_u32 v7, 16, v7
  v_lshlrev_b32 v8, 7, v7
  v_lshl_add_u32 v8, v5, 3, v8
  v_sub_u32 v9, v7, s3
  v_cmp_gt_u32 vcc, 196, v9
  s_mov_b64 exec, vcc
  buffer_store_dwordx2 v[24:25], v8, s[20:23], 0 offen offset:0
  buffer_store_dwordx2 v[26:27], v8, s[20:23], 0 offen offset:32
  buffer_store_dwordx2 v[28:29], v8, s[20:23], 0 offen offset:64
  buffer_store_dwordx2 v[30:31], v8, s[20:23], 0 offen offset:96
  s_mov_b64 exec, -1
K2_END:
  s_endpgm
.section .rodata,"a"
.p2align 6
.amdhsa_kernel spmm_sort_kernel
  .amdhsa_next_free_vgpr 64
  .amdhsa_next_free_sgpr 64
  .amdhsa_accum_offset 64
  .amdhsa_group_segment_fixed_size 0
  .amdhsa_kernarg_size 64
  .amdhsa_user_sgpr_count 2
  .amdhsa_user_sgpr_kernarg_segment_ptr 1
  .amdhsa_system_sgpr_workgroup_id_x 1
.end_amdhsa_kernel
.p2align 6
.amdhsa_kernel spmm_agg_kernel
  .amdhsa_next_free_vgpr 128
  .amdhsa_next_free_sgpr 64
  .amdhsa_accum_offset 128
  .amdhsa_group_segment_fixed_size 0
  .amdhsa_kernarg_size 64
  .amdhsa_user_sgpr_count 2
  .amdhsa_user_sgpr_kernarg_segment_ptr 1
  .amdhsa_system_sgpr_workgroup_id_x 1
.end_amdhsa_kernel
```
